```python
import torch

def _softmax(x, axis=-1):
    return torch.softmax(x, dim=axis)
def _gelu(x):
    return torch.nn.functional.gelu(x, approximate="tanh")
def _silu(x):
    return torch.nn.functional.silu(x)
def _sigmoid(x):
    return torch.sigmoid(x)
def _layernorm(x, axis=-1, eps=1e-5):
    m = x.mean(dim=axis, keepdim=True)
    v = x.var(dim=axis, keepdim=True, unbiased=False)
    return (x - m) / torch.sqrt(v + eps)
def _scatter_add(tgt, idx, src, axis=0):
    return tgt.clone().index_add_(axis, idx, src)
def _segment_sum(src, seg, n):
    out = torch.zeros((n,) + src.shape[1:], dtype=src.dtype)
    return out.index_add_(0, seg, src)
def _pad(x, pw):
    flat = tuple(v for pair in reversed(pw) for v in pair)
    return torch.nn.functional.pad(x, flat)

kernel_name = 'parallel_sum__sliding_block_cached__dense_activation_silu__decode'

def setup_inputs():

    _w = (lambda a: (lambda t: t.to(torch.bfloat16) if t.is_floating_point() else t)(torch.as_tensor(a)))
    def _A_setup():
        B, Sq, D = 1, 1, 640
        Hq, Hkv, Sk, Dh = 32, 32, 4096, 128
        assert Hq % Hkv == 0, (Hq, Hkv)
        return {
            "x": _w((lambda *s: torch.randn(*s, dtype=torch.bfloat16) * 0.05)(B, Sq, D)),
            "k_cache": _w((lambda *s: torch.randn(*s, dtype=torch.bfloat16) * 3.2)(B, Hkv, Sk, Dh)),
            "v_cache": _w((lambda *s: torch.randn(*s, dtype=torch.bfloat16) * 0.8)(B, Hkv, Sk, Dh)),
            "wq": _w((lambda *s: torch.randn(*s, dtype=torch.bfloat16) * 3.2)(D, Hq * Dh) * (D ** -0.5)),
            "wo": _w((lambda *s: torch.randn(*s, dtype=torch.bfloat16) * 0.8)(Hq * Dh, D) * ((Hq * Dh) ** -0.5)),
        }
    _A_in = _A_setup()

    def _B_setup():
        B, S, D, F = 1, 1, 640, 1728
        return {
            "x": _w((lambda *s: torch.randn(*s, dtype=torch.bfloat16) * 0.05)(B, S, D)),
            "w1": _w((lambda *s: torch.randn(*s, dtype=torch.bfloat16) * 3.2)(D, F) * (D ** -0.5)),
            "w2": _w((lambda *s: torch.randn(*s, dtype=torch.bfloat16) * 0.4)(F, D) * (F ** -0.5)),
        }
    _B_in = _B_setup()

    return {
        "A_x": _A_in["x"],
        "A_k_cache": _A_in["k_cache"],
        "A_v_cache": _A_in["v_cache"],
        "A_wq": _A_in["wq"],
        "A_wo": _A_in["wo"],
        "B_x": _B_in["x"],
        "B_w1": _B_in["w1"],
        "B_w2": _B_in["w2"],
    }

def reference(A_x, A_k_cache, A_v_cache, A_wq, A_wo, B_x, B_w1, B_w2):
    def _A_ref(x, k_cache, v_cache, wq, wo):
        B, Sq, D = x.shape
        Hq, Dh = 32, 128
        Hkv, Sk = k_cache.shape[1], k_cache.shape[2]
        W = min(4096, max(256, Sk // 4))
        rep = Hq // Hkv
        q = (lambda x, *d: x.permute(*d))((x @ wq).reshape(B, Sq, Hq, Dh), 0, 2, 1, 3)
        k = (lambda x, n, axis: torch.repeat_interleave(x, n, dim=axis))(k_cache[:, :, Sk - W:, :], rep, axis=1)
        v = (lambda x, n, axis: torch.repeat_interleave(x, n, dim=axis))(v_cache[:, :, Sk - W:, :], rep, axis=1)
        scores = torch.einsum("bhqd,bhkd->bhqk", q, k) * (Dh ** -0.5)
        p = _softmax(scores, axis=-1)
        o = torch.einsum("bhqk,bhkd->bhqd", p, v)
        return (lambda x, *d: x.permute(*d))(o, 0, 2, 1, 3).reshape(B, Sq, Hq * Dh) @ wo

    def _B_ref(x, w1, w2):
        h = torch.einsum("bsd,df->bsf", x, w1)
        h = _silu(h)
        out = torch.einsum("bsf,fd->bsd", h, w2)
        return out

    x = A_x
    xn = _layernorm(x, axis=-1)
    return x + _A_ref(xn, A_k_cache, A_v_cache, A_wq, A_wo) + _B_ref(xn, B_w1, B_w2)
```

```asm
; @launch grid=(256,1,1) block=(640,1,1) lds=7552
.amdgcn_target "amdgcn-amd-amdhsa--gfx950"
.text
.p2align 12
.globl parallel_sum__sliding_block_cached__dense_activation_silu__decode_kernel
.p2align 8
.type parallel_sum__sliding_block_cached__dense_activation_silu__decode_kernel,@function
parallel_sum__sliding_block_cached__dense_activation_silu__decode_kernel:

  s_cmp_ge_u32 s2, 256
  s_cbranch_scc1 L_end
  s_load_dwordx16 s[4:19], s[0:1], 0
  s_load_dwordx4 s[20:23], s[0:1], 64
  s_load_dwordx2 s[24:25], s[0:1], 80
  v_lshrrev_b32 v4, 6, v0
  v_and_b32 v0, 63, v0
  v_mov_b32 v1, 0
  v_readfirstlane_b32 s26, v4
  v_and_b32 v2, 15, v0
  v_lshrrev_b32 v3, 4, v0
  v_lshlrev_b32 v4, 2, v0
  s_mov_b64 exec, 0xffff
  ds_write_b32 v4, v1
  s_mov_b64 exec, -1
  s_cmp_lt_u32 s26, 8
  s_cbranch_scc1 L_nopf
  s_getpc_b64 s[30:31]
  s_and_b32 s30, s30, 0xffffff00
  s_lshr_b32 s32, s2, 3
  s_and_b32 s32, s32, 3
  s_lshl_b32 s32, s32, 1
  s_add_u32 s32, s32, s26
  s_sub_u32 s32, s32, 7
  s_lshl_b32 s32, s32, 10
  v_lshl_add_u32 v5, v0, 4, s32
  global_load_dwordx4 v[20:23], v5, s[30:31] offset:0
L_nopf:
  s_and_b32 s27, s2, 7
  s_lshr_b32 s28, s2, 3
  s_lshr_b32 s29, s28, 3
  s_lshl_b32 s27, s27, 2
  s_add_u32 s27, s27, s29
  s_and_b32 s28, s28, 7
  s_lshl_b32 s29, s27, 3
  s_add_u32 s29, s29, s28
  s_mul_i32 s31, s28, 160
  s_mov_b32 s62, s27
  s_mov_b32 s63, s28
  s_mov_b32 s66, s29
  s_mov_b32 s67, s31
  v_lshlrev_b32 v16, 4, v2
  v_lshlrev_b32 v17, 4, v0
  v_mov_b32 v18, 1
  v_lshlrev_b32 v19, 3, v0
  s_cmp_eq_u32 s26, 0
  s_cbranch_scc1 L_A0
  s_cmp_eq_u32 s26, 1
  s_cbranch_scc1 L_B0
  s_cmp_ge_u32 s26, 6
  s_waitcnt lgkmcnt(0)
  s_barrier
  s_cbranch_scc1 L_W
  s_branch L_KV
L_B0:
  v_lshrrev_b32 v6, 3, v2
  v_lshl_add_u32 v6, v3, 1, v6
  v_mul_u32_u24 v27, 34560, v6
  v_and_b32 v7, 7, v2
  v_lshl_add_u32 v27, v7, 4, v27
  s_mul_i32 s33, s63, 276480
  s_lshl_b32 s35, s62, 7
  s_add_u32 s33, s33, s35
  s_cmp_ge_u32 s62, 27
  s_cselect_b32 s33, 0x7f000000, s33
  s_movk_i32 s34, 3456
  s_waitcnt lgkmcnt(0)
  s_mov_b32 s44, s16
  s_mov_b32 s45, s17
  s_mov_b32 s46, 2211840
  s_mov_b32 s47, 0x20000
  buffer_load_dwordx4 v[48:51], v27, s[44:47], s33 offen nt
  s_add_u32 s33, s33, s34
  buffer_load_dwordx4 v[52:55], v27, s[44:47], s33 offen nt
  s_add_u32 s33, s33, s34
  buffer_load_dwordx4 v[56:59], v27, s[44:47], s33 offen nt
  s_add_u32 s33, s33, s34
  buffer_load_dwordx4 v[60:63], v27, s[44:47], s33 offen nt
  s_add_u32 s33, s33, s34
  buffer_load_dwordx4 v[64:67], v27, s[44:47], s33 offen nt
  s_add_u32 s33, s33, s34
  buffer_load_dwordx4 v[68:71], v27, s[44:47], s33 offen nt
  s_add_u32 s33, s33, s34
  buffer_load_dwordx4 v[72:75], v27, s[44:47], s33 offen nt
  s_add_u32 s33, s33, s34
  buffer_load_dwordx4 v[76:79], v27, s[44:47], s33 offen nt
  s_add_u32 s33, s33, s34
  buffer_load_dwordx4 v[80:83], v27, s[44:47], s33 offen nt
  s_add_u32 s33, s33, s34
  buffer_load_dwordx4 v[84:87], v27, s[44:47], s33 offen nt
  s_barrier
  s_branch L_B
L_A0:
  v_lshl_add_u32 v26, v3, 13, v16
  s_mul_i32 s32, s63, 655360
  s_lshl_b32 s33, s62, 8
  s_add_u32 s32, s32, s33
  s_mov_b32 s34, 32768
  s_waitcnt lgkmcnt(0)
  s_mov_b32 s40, s4
  s_mov_b32 s41, s5
  s_mov_b32 s42, 1280
  s_mov_b32 s43, 0x20000
  buffer_load_dwordx4 v[20:23], v17, s[40:43], 0 offen
  buffer_load_dword v24, v4, s[40:43], 0 offen offset:1024
  buffer_load_dword v28, v4, s[40:43], s67 offen
  s_mov_b32 s44, s10
  s_mov_b32 s45, s11
  s_mov_b32 s46, 5242880
  s_mov_b32 s47, 0x20000
  buffer_load_dwordx4 v[48:51], v26, s[44:47], s32 offen nt
  s_add_u32 s32, s32, s34
  buffer_load_dwordx4 v[52:55], v26, s[44:47], s32 offen nt
  s_add_u32 s32, s32, s34
  buffer_load_dwordx4 v[56:59], v26, s[44:47], s32 offen nt
  s_add_u32 s32, s32, s34
  buffer_load_dwordx4 v[60:63], v26, s[44:47], s32 offen nt
  s_add_u32 s32, s32, s34
  buffer_load_dwordx4 v[64:67], v26, s[44:47], s32 offen nt
  s_add_u32 s32, s32, s34
  buffer_load_dwordx4 v[68:71], v26, s[44:47], s32 offen nt
  s_add_u32 s32, s32, s34
  buffer_load_dwordx4 v[72:75], v26, s[44:47], s32 offen nt
  s_add_u32 s32, s32, s34
  buffer_load_dwordx4 v[76:79], v26, s[44:47], s32 offen nt
  s_add_u32 s32, s32, s34
  buffer_load_dwordx4 v[80:83], v26, s[44:47], s32 offen nt
  s_add_u32 s32, s32, s34
  buffer_load_dwordx4 v[84:87], v26, s[44:47], s32 offen nt
  s_add_u32 s32, s32, s34
  buffer_load_dwordx4 v[88:91], v26, s[44:47], s32 offen nt
  s_add_u32 s32, s32, s34
  buffer_load_dwordx4 v[92:95], v26, s[44:47], s32 offen nt
  s_add_u32 s32, s32, s34
  buffer_load_dwordx4 v[96:99], v26, s[44:47], s32 offen nt
  s_add_u32 s32, s32, s34
  buffer_load_dwordx4 v[100:103], v26, s[44:47], s32 offen nt
  s_add_u32 s32, s32, s34
  buffer_load_dwordx4 v[104:107], v26, s[44:47], s32 offen nt
  s_add_u32 s32, s32, s34
  buffer_load_dwordx4 v[108:111], v26, s[44:47], s32 offen nt
  s_add_u32 s32, s32, s34
  buffer_load_dwordx4 v[112:115], v26, s[44:47], s32 offen nt
  s_add_u32 s32, s32, s34
  buffer_load_dwordx4 v[116:119], v26, s[44:47], s32 offen nt
  s_add_u32 s32, s32, s34
  buffer_load_dwordx4 v[120:123], v26, s[44:47], s32 offen nt
  s_add_u32 s32, s32, s34
  buffer_load_dwordx4 v[124:127], v26, s[44:47], s32 offen nt
  s_setprio 3
  s_barrier
  s_load_dword s30, s[24:25], 0
  s_mov_b32 s36, s24
  s_mov_b32 s37, s25
  s_mov_b32 s38, 268435456
  s_mov_b32 s39, 0x20000
  v_and_b32 v4, 1, v0
  v_lshlrev_b32 v4, 4, v4
  v_mov_b32 v5, 0xffff
  v_lshlrev_b32 v5, v4, v5
  v_bfe_u32 v4, v0, 1, 2
  v_cmp_eq_u32 vcc, 0, v4
  s_nop 1
  v_cndmask_b32 v12, 0, v5, vcc
  v_cmp_eq_u32 vcc, 1, v4
  s_nop 1
  v_cndmask_b32 v13, 0, v5, vcc
  v_cmp_eq_u32 vcc, 2, v4
  s_nop 1
  v_cndmask_b32 v14, 0, v5, vcc
  v_cmp_eq_u32 vcc, 3, v4
  s_nop 1
  v_cndmask_b32 v15, 0, v5, vcc
  s_mov_b32 s64, 0
  s_mov_b32 s65, -1
  v_mul_u32_u24 v9, 80, v3
  v_and_b32 v29, 1, v0
  v_mul_u32_u24 v29, 160, v29
  v_lshrrev_b32 v10, 1, v0
  v_lshl_add_u32 v29, v10, 2, v29
  v_add_u32 v29, 6016, v29
  s_waitcnt vmcnt(20)
  v_lshlrev_b32 v30, 16, v20
  v_and_b32 v31, 0xffff0000, v20
  v_lshlrev_b32 v32, 16, v21
  v_and_b32 v33, 0xffff0000, v21
  v_lshlrev_b32 v34, 16, v22
  v_and_b32 v35, 0xffff0000, v22
  v_lshlrev_b32 v36, 16, v23
  v_and_b32 v37, 0xffff0000, v23
  v_lshlrev_b32 v38, 16, v24
  v_and_b32 v39, 0xffff0000, v24
  v_add_f32 v4, v30, v31
  v_add_f32 v5, v32, v33
  v_add_f32 v4, v4, v34
  v_add_f32 v5, v5, v35
  v_add_f32 v4, v4, v36
  v_add_f32 v5, v5, v37
  v_add_f32 v4, v4, v38
  v_add_f32 v5, v5, v39
  v_add_f32 v4, v4, v5
  s_nop 1
  v_add_f32_dpp v4, v4, v4 row_ror:8 row_mask:0xf bank_mask:0xf
  s_nop 1
  v_add_f32_dpp v4, v4, v4 row_ror:4 row_mask:0xf bank_mask:0xf
  s_nop 1
  v_add_f32_dpp v4, v4, v4 row_ror:2 row_mask:0xf bank_mask:0xf
  s_nop 1
  v_add_f32_dpp v4, v4, v4 row_ror:1 row_mask:0xf bank_mask:0xf
  v_mov_b32 v5, v4
  s_nop 1
  v_permlane16_swap_b32 v4, v5
  v_add_f32 v4, v4, v5
  v_mov_b32 v5, v4
  s_nop 1
  v_permlane32_swap_b32 v4, v5
  v_add_f32 v4, v4, v5
  v_mul_f32 v4, 0x3ACCCCCD, v4
  v_sub_f32 v30, v30, v4
  v_sub_f32 v31, v31, v4
  v_sub_f32 v32, v32, v4
  v_sub_f32 v33, v33, v4
  v_sub_f32 v34, v34, v4
  v_sub_f32 v35, v35, v4
  v_sub_f32 v36, v36, v4
  v_sub_f32 v37, v37, v4
  v_sub_f32 v38, v38, v4
  v_sub_f32 v39, v39, v4
  v_mul_f32 v6, v30, v30
  v_mul_f32 v7, v31, v31
  v_fmac_f32 v6, v32, v32
  v_fmac_f32 v7, v33, v33
  v_fmac_f32 v6, v34, v34
  v_fmac_f32 v7, v35, v35
  v_fmac_f32 v6, v36, v36
  v_fmac_f32 v7, v37, v37
  v_fmac_f32 v6, v38, v38
  v_fmac_f32 v7, v39, v39
  v_add_f32 v6, v6, v7
  v_cvt_pk_bf16_f32 v4, v4, v4
  v_and_b32 v4, 0xffff0000, v4
  s_nop 1
  v_add_f32_dpp v6, v6, v6 row_ror:8 row_mask:0xf bank_mask:0xf
  s_nop 1
  v_add_f32_dpp v6, v6, v6 row_ror:4 row_mask:0xf bank_mask:0xf
  s_nop 1
  v_add_f32_dpp v6, v6, v6 row_ror:2 row_mask:0xf bank_mask:0xf
  s_nop 1
  v_add_f32_dpp v6, v6, v6 row_ror:1 row_mask:0xf bank_mask:0xf
  v_mov_b32 v5, v6
  s_nop 1
  v_permlane16_swap_b32 v6, v5
  v_add_f32 v6, v6, v5
  v_mov_b32 v5, v6
  s_nop 1
  v_permlane32_swap_b32 v6, v5
  v_add_f32 v6, v6, v5
  v_mul_f32 v6, 0x3ACCCCCD, v6
  v_cvt_pk_bf16_f32 v6, v6, v6
  v_and_b32 v6, 0xffff0000, v6
  v_add_f32 v6, 0x3727C5AC, v6
  v_cvt_pk_bf16_f32 v6, v6, v6
  v_and_b32 v6, 0xffff0000, v6
  v_sqrt_f32 v7, v6
  v_lshlrev_b32 v30, 16, v28
  v_and_b32 v31, 0xffff0000, v28
  v_sub_f32 v30, v30, v4
  v_sub_f32 v31, v31, v4
  v_rcp_f32 v5, v7
  v_fma_f32 v10, -v7, v7, v6
  v_mul_f32 v5, 0.5, v5
  v_fmac_f32 v7, v10, v5
  v_cvt_pk_bf16_f32 v7, v7, v7
  v_and_b32 v7, 0xffff0000, v7
  v_rcp_f32 v5, v7
  v_cvt_pk_bf16_f32 v30, v30, v31
  v_and_b32 v31, 0xffff0000, v30
  v_lshlrev_b32 v30, 16, v30
  v_mul_f32 v32, v30, v5
  v_mul_f32 v33, v31, v5
  v_fma_f32 v30, -v32, v7, v30
  v_fma_f32 v31, -v33, v7, v31
  v_fmac_f32 v32, v30, v5
  v_fmac_f32 v33, v31, v5
  v_cvt_pk_bf16_f32 v32, v32, v32
  v_cvt_pk_bf16_f32 v33, v33, v33
  s_mov_b32 exec_hi, 0xff
  ds_write_b64 v19, v[32:33] offset:5632
  ds_write2_b32 v29, v32, v33 offset0:0 offset1:20
  s_mov_b64 exec, 1
  ds_add_u32 v1, v18 offset:0
  s_mov_b64 exec, -1
  ds_read_b128 v[20:23], v9 offset:6016
  ds_read_b128 v[24:27], v9 offset:6032
  ds_read_b128 v[28:31], v9 offset:6048
  ds_read_b128 v[32:35], v9 offset:6064
  ds_read_b128 v[36:39], v9 offset:6080
  s_lshl_b32 s32, s66, 10
  s_add_u32 s32, s32, 4096
  s_add_u32 s33, s32, 1048576
  s_lshl_b32 s68, s27, 13
  s_add_u32 s68, s68, 1052672
  s_add_u32 s69, s68, 4096
  s_lshl_b32 s34, s27, 12
  s_add_u32 s34, s34, 1314816
  s_lshl_b32 s56, s27, 3
  s_add_u32 s56, s56, s31
  s_mov_b32 s52, s20
  s_mov_b32 s53, s21
  s_mov_b32 s54, 1280
  s_mov_b32 s55, 0x20000
  s_waitcnt lgkmcnt(0)
  s_mul_i32 s60, s30, 0x9E3779B1
  s_add_u32 s60, s60, 0x7F4A7C15
  s_xor_b32 s61, s30, 0x5bd1e995
  s_mul_i32 s61, s61, 0x85EBCA6B
  s_add_u32 s61, s61, 0x1B873593
  v_and_b32 v40, v20, v12
  v_and_b32 v41, v20, v13
  v_and_b32 v42, v20, v14
  v_and_b32 v43, v20, v15
  v_and_b32 v44, v21, v12
  v_and_b32 v45, v21, v13
  v_and_b32 v46, v21, v14
  v_and_b32 v47, v21, v15
  s_waitcnt vmcnt(19)
  v_mfma_f32_16x16x32_bf16 v[4:7], v[40:43], v[48:51], 0
  v_and_b32 v40, v22, v12
  v_and_b32 v41, v22, v13
  v_and_b32 v42, v22, v14
  v_and_b32 v43, v22, v15
  s_waitcnt vmcnt(18)
  v_mfma_f32_16x16x32_bf16 v[4:7], v[44:47], v[52:55], v[4:7]
  v_and_b32 v44, v23, v12
  v_and_b32 v45, v23, v13
  v_and_b32 v46, v23, v14
  v_and_b32 v47, v23, v15
  s_waitcnt vmcnt(17)
  v_mfma_f32_16x16x32_bf16 v[4:7], v[40:43], v[56:59], v[4:7]
  v_and_b32 v40, v24, v12
  v_and_b32 v41, v24, v13
  v_and_b32 v42, v24, v14
  v_and_b32 v43, v24, v15
  s_waitcnt vmcnt(16)
  v_mfma_f32_16x16x32_bf16 v[4:7], v[44:47], v[60:63], v[4:7]
  v_and_b32 v44, v25, v12
  v_and_b32 v45, v25, v13
  v_and_b32 v46, v25, v14
  v_and_b32 v47, v25, v15
  s_waitcnt vmcnt(15)
  v_mfma_f32_16x16x32_bf16 v[4:7], v[40:43], v[64:67], v[4:7]
  v_and_b32 v40, v26, v12
  v_and_b32 v41, v26, v13
  v_and_b32 v42, v26, v14
  v_and_b32 v43, v26, v15
  s_waitcnt vmcnt(14)
  v_mfma_f32_16x16x32_bf16 v[4:7], v[44:47], v[68:71], v[4:7]
  v_and_b32 v44, v27, v12
  v_and_b32 v45, v27, v13
  v_and_b32 v46, v27, v14
  v_and_b32 v47, v27, v15
  s_waitcnt vmcnt(13)
  v_mfma_f32_16x16x32_bf16 v[4:7], v[40:43], v[72:75], v[4:7]
  v_and_b32 v40, v28, v12
  v_and_b32 v41, v28, v13
  v_and_b32 v42, v28, v14
  v_and_b32 v43, v28, v15
  s_waitcnt vmcnt(12)
  v_mfma_f32_16x16x32_bf16 v[4:7], v[44:47], v[76:79], v[4:7]
  v_and_b32 v44, v29, v12
  v_and_b32 v45, v29, v13
  v_and_b32 v46, v29, v14
  v_and_b32 v47, v29, v15
  s_waitcnt vmcnt(11)
  v_mfma_f32_16x16x32_bf16 v[4:7], v[40:43], v[80:83], v[4:7]
  v_and_b32 v40, v30, v12
  v_and_b32 v41, v30, v13
  v_and_b32 v42, v30, v14
  v_and_b32 v43, v30, v15
  s_waitcnt vmcnt(10)
  v_mfma_f32_16x16x32_bf16 v[4:7], v[44:47], v[84:87], v[4:7]
  v_and_b32 v44, v31, v12
  v_and_b32 v45, v31, v13
  v_and_b32 v46, v31, v14
  v_and_b32 v47, v31, v15
  s_waitcnt vmcnt(9)
  v_mfma_f32_16x16x32_bf16 v[4:7], v[40:43], v[88:91], v[4:7]
  v_and_b32 v40, v32, v12
  v_and_b32 v41, v32, v13
  v_and_b32 v42, v32, v14
  v_and_b32 v43, v32, v15
  s_waitcnt vmcnt(8)
  v_mfma_f32_16x16x32_bf16 v[4:7], v[44:47], v[92:95], v[4:7]
  v_and_b32 v44, v33, v12
  v_and_b32 v45, v33, v13
  v_and_b32 v46, v33, v14
  v_and_b32 v47, v33, v15
  s_waitcnt vmcnt(7)
  v_mfma_f32_16x16x32_bf16 v[4:7], v[40:43], v[96:99], v[4:7]
  v_and_b32 v40, v34, v12
  v_and_b32 v41, v34, v13
  v_and_b32 v42, v34, v14
  v_and_b32 v43, v34, v15
  s_waitcnt vmcnt(6)
  v_mfma_f32_16x16x32_bf16 v[4:7], v[44:47], v[100:103], v[4:7]
  v_and_b32 v44, v35, v12
  v_and_b32 v45, v35, v13
  v_and_b32 v46, v35, v14
  v_and_b32 v47, v35, v15
  s_waitcnt vmcnt(5)
  v_mfma_f32_16x16x32_bf16 v[4:7], v[40:43], v[104:107], v[4:7]
  v_and_b32 v40, v36, v12
  v_and_b32 v41, v36, v13
  v_and_b32 v42, v36, v14
  v_and_b32 v43, v36, v15
  s_waitcnt vmcnt(4)
  v_mfma_f32_16x16x32_bf16 v[4:7], v[44:47], v[108:111], v[4:7]
  v_and_b32 v44, v37, v12
  v_and_b32 v45, v37, v13
  v_and_b32 v46, v37, v14
  v_and_b32 v47, v37, v15
  s_waitcnt vmcnt(3)
  v_mfma_f32_16x16x32_bf16 v[4:7], v[40:43], v[112:115], v[4:7]
  v_and_b32 v40, v38, v12
  v_and_b32 v41, v38, v13
  v_and_b32 v42, v38, v14
  v_and_b32 v43, v38, v15
  s_waitcnt vmcnt(2)
  v_mfma_f32_16x16x32_bf16 v[4:7], v[44:47], v[116:119], v[4:7]
  v_and_b32 v44, v39, v12
  v_and_b32 v45, v39, v13
  v_and_b32 v46, v39, v14
  v_and_b32 v47, v39, v15
  s_waitcnt vmcnt(1)
  v_mfma_f32_16x16x32_bf16 v[4:7], v[40:43], v[120:123], v[4:7]
  s_nop 0
  s_waitcnt vmcnt(0)
  v_mfma_f32_16x16x32_bf16 v[4:7], v[44:47], v[124:127], v[4:7]
  v_mov_b32 v9, s60
  v_mov_b32 v11, s61
  v_lshrrev_b32 v26, 5, v0
  v_lshlrev_b32 v26, 2, v26
  v_and_b32 v20, 1, v3
  v_lshl_add_u32 v27, v20, 3, v16
  v_lshrrev_b32 v20, 1, v3
  v_lshl_add_u32 v27, v20, 2, v27
  s_nop 0
  v_cndmask_b32 v8, v4, v6, s[64:65]
  v_cndmask_b32 v10, v5, v7, s[64:65]
  buffer_store_dwordx4 v[8:11], v17, s[36:39], s33 offen
  s_mov_b64 exec, 1
  ds_add_u32 v1, v18 offset:28
  s_mov_b64 exec, -1
  s_movk_i32 s72, 0
  s_mov_b32 s71, 262144
  s_waitcnt vmcnt(0)
  v_mov_b32 v104, v8
  v_mov_b32 v105, v9
  v_mov_b32 v106, v10
  v_mov_b32 v107, v11
  s_mov_b32 s58, s32
L_x1:
  buffer_load_dwordx4 v[48:51], v17, s[36:39], s68 offen offset:0 sc1
  buffer_load_dwordx4 v[52:55], v17, s[36:39], s68 offen offset:1024 sc1
  buffer_load_dwordx4 v[56:59], v17, s[36:39], s68 offen offset:2048 sc1
  buffer_load_dwordx4 v[60:63], v17, s[36:39], s68 offen offset:3072 sc1
  buffer_load_dwordx4 v[64:67], v17, s[36:39], s69 offen offset:0 sc1
  buffer_load_dwordx4 v[68:71], v17, s[36:39], s69 offen offset:1024 sc1
  buffer_load_dwordx4 v[72:75], v17, s[36:39], s69 offen offset:2048 sc1
  buffer_load_dwordx4 v[76:79], v17, s[36:39], s69 offen offset:3072 sc1
  buffer_load_dwordx4 v[80:83], v17, s[36:39], s34 offen offset:0 sc1
  buffer_load_dwordx4 v[84:87], v17, s[36:39], s34 offen offset:1024 sc1
  buffer_load_dwordx4 v[88:91], v17, s[36:39], s34 offen offset:2048 sc1
  buffer_load_dwordx4 v[92:95], v17, s[36:39], s34 offen offset:3072 sc1
  buffer_load_dword v25, v26, s[40:43], s56 offen
  v_mov_b32 v4, 0
  s_waitcnt vmcnt(12)
  v_sad_u32 v4, v49, s60, v4 clamp
  v_sad_u32 v4, v51, s61, v4 clamp
  s_waitcnt vmcnt(11)
  v_sad_u32 v4, v53, s60, v4 clamp
  v_sad_u32 v4, v55, s61, v4 clamp
  v_add_f32 v6, v48, v52
  v_add_f32 v7, v50, v54
  s_waitcnt vmcnt(10)
  v_sad_u32 v4, v57, s60, v4 clamp
  v_sad_u32 v4, v59, s61, v4 clamp
  v_add_f32 v6, v6, v56
  v_add_f32 v7, v7, v58
  s_waitcnt vmcnt(9)
  v_sad_u32 v4, v61, s60, v4 clamp
  v_sad_u32 v4, v63, s61, v4 clamp
  v_add_f32 v6, v6, v60
  v_add_f32 v7, v7, v62
  s_waitcnt vmcnt(8)
  v_sad_u32 v4, v65, s60, v4 clamp
  v_sad_u32 v4, v67, s61, v4 clamp
  v_add_f32 v6, v6, v64
  v_add_f32 v7, v7, v66
  s_waitcnt vmcnt(7)
  v_sad_u32 v4, v69, s60, v4 clamp
  v_sad_u32 v4, v71, s61, v4 clamp
  v_add_f32 v6, v6, v68
  v_add_f32 v7, v7, v70
  s_waitcnt vmcnt(6)
  v_sad_u32 v4, v73, s60, v4 clamp
  v_sad_u32 v4, v75, s61, v4 clamp
  v_add_f32 v6, v6, v72
  v_add_f32 v7, v7, v74
  s_waitcnt vmcnt(5)
  v_sad_u32 v4, v77, s60, v4 clamp
  v_sad_u32 v4, v79, s61, v4 clamp
  v_add_f32 v6, v6, v76
  v_add_f32 v7, v7, v78
  v_cmp_ne_u32 vcc, 0, v4
  v_cvt_pk_bf16_f32 v6, v6, v7
  s_cbranch_vccz L_x1ok
  s_sub_u32 s72, s72, 1
  s_cbranch_scc0 L_x1
  s_mov_b32 s72, 0
  buffer_store_dwordx4 v[104:107], v17, s[36:39], s58 offen sc1
  s_mov_b32 s59, s71
  s_mov_b32 s71, 262144
  s_mov_b32 s72, 0
L_spin1:
  ds_read_b32 v108, v1 offset:32
  s_sub_u32 s71, s71, 1
  s_cbranch_scc1 L_spin1_x
  s_waitcnt lgkmcnt(0)
  v_readfirstlane_b32 s72, v108
  s_cmp_ge_u32 s72, 1
  s_cbranch_scc0 L_spin1
L_spin1_x:
  s_mov_b32 s71, s59
  s_mov_b32 s72, 0
  ds_read_b128 v[108:111], v17 offset:6400
  s_lshl_b32 s59, s66, 9
  s_add_u32 s59, s59, 266240
  s_mov_b32 exec_hi, 0
  s_waitcnt lgkmcnt(0)
  buffer_store_dwordx4 v[108:111], v17, s[36:39], s59 offen sc1
  s_mov_b64 exec, -1
  s_xor_b32 s68, s68, 1048576
  s_xor_b32 s69, s69, 1048576
  s_xor_b32 s34, s34, 1048576
  s_sub_u32 s71, s71, 1
  s_cbranch_scc0 L_x1
L_x1ok:
  ds_write_b32 v27, v6 offset:256
  s_mov_b64 exec, 1
  ds_add_u32 v1, v18 offset:4
  s_mov_b64 exec, -1
  s_lshl_b32 s56, s29, 7
  s_add_u32 s56, s56, 659456
  s_lshl_b32 s57, s29, 10
  s_add_u32 s57, s57, 397312
  s_and_b32 s63, s68, 1048576
  s_lshl_b32 s68, s27, 13
  s_add_u32 s68, s68, 397312
  s_add_u32 s68, s68, s63
  s_add_u32 s69, s68, 4096
  s_lshl_b32 s73, s27, 10
  s_add_u32 s73, s73, 659456
  s_add_u32 s73, s73, s63
  s_add_u32 s74, s56, 1048576
  s_add_u32 s75, s57, 1048576
  v_and_b32 v29, 7, v0
  v_lshlrev_b32 v28, 5, v29
  v_bfe_u32 v5, v0, 3, 1
  v_lshl_add_u32 v28, v5, 4, v28
  v_bfe_u32 v5, v0, 4, 1
  v_lshl_add_u32 v28, v5, 3, v28
  v_lshlrev_b32 v27, 7, v29
  s_waitcnt vmcnt(1)
  s_mov_b32 s71, 262144
L_hchk:
  v_mov_b32 v29, 0
  v_sad_u32 v29, v81, s60, v29 clamp
  v_sad_u32 v29, v83, s61, v29 clamp
  v_sad_u32 v29, v85, s60, v29 clamp
  v_sad_u32 v29, v87, s61, v29 clamp
  v_sad_u32 v29, v89, s60, v29 clamp
  v_sad_u32 v29, v91, s61, v29 clamp
  v_sad_u32 v29, v93, s60, v29 clamp
  v_sad_u32 v29, v95, s61, v29 clamp
  v_cmp_ne_u32 vcc, 0, v29
  s_cbranch_vccz L_hok
  s_sub_u32 s71, s71, 1
  s_cbranch_scc1 L_hok
  s_xor_b32 s34, s34, 1048576
  buffer_store_dwordx4 v[104:107], v17, s[36:39], s58 offen sc1
  s_mov_b32 s59, s71
  s_mov_b32 s71, 262144
  s_mov_b32 s72, 0
L_spin2:
  ds_read_b32 v108, v1 offset:32
  s_sub_u32 s71, s71, 1
  s_cbranch_scc1 L_spin2_x
  s_waitcnt lgkmcnt(0)
  v_readfirstlane_b32 s72, v108
  s_cmp_ge_u32 s72, 1
  s_cbranch_scc0 L_spin2
L_spin2_x:
  s_mov_b32 s71, s59
  s_mov_b32 s72, 0
  ds_read_b128 v[108:111], v17 offset:6400
  s_lshl_b32 s59, s66, 9
  s_add_u32 s59, s59, 266240
  s_mov_b32 exec_hi, 0
  s_waitcnt lgkmcnt(0)
  buffer_store_dwordx4 v[108:111], v17, s[36:39], s59 offen sc1
  s_mov_b64 exec, -1
  buffer_load_dwordx4 v[80:83], v17, s[36:39], s34 offen offset:0 sc1
  buffer_load_dwordx4 v[84:87], v17, s[36:39], s34 offen offset:1024 sc1
  buffer_load_dwordx4 v[88:91], v17, s[36:39], s34 offen offset:2048 sc1
  buffer_load_dwordx4 v[92:95], v17, s[36:39], s34 offen offset:3072 sc1
  s_waitcnt vmcnt(0)
  s_branch L_hchk
L_hok:
  v_add_f32 v80, v80, v84
  v_add_f32 v82, v82, v86
  v_add_f32 v88, v88, v92
  v_add_f32 v90, v90, v94
  v_add_f32 v80, v80, v88
  v_add_f32 v82, v82, v90
  v_mov_b32 v81, v80
  v_mov_b32 v83, v82
  s_nop 0
  v_permlane32_swap_b32 v80, v81
  v_permlane32_swap_b32 v82, v83
  v_add_f32 v80, v80, v81
  v_add_f32 v82, v82, v83
  v_cvt_pk_bf16_f32 v80, v80, v82
  v_and_b32 v81, 0xffff0000, v80
  v_lshlrev_b32 v80, 16, v80
  v_mul_f32 v84, 0xbfb8aa3b, v80
  v_mul_f32 v85, 0xbfb8aa3b, v81
  v_exp_f32 v84, v84
  v_exp_f32 v85, v85
  s_nop 0
  v_add_f32 v84, 1.0, v84
  v_add_f32 v85, 1.0, v85
  v_rcp_f32 v84, v84
  v_rcp_f32 v85, v85
  s_nop 0
  v_mul_f32 v80, v80, v84
  v_mul_f32 v81, v81, v85
  v_cvt_pk_bf16_f32 v80, v80, v80
  v_cvt_pk_bf16_f32 v81, v81, v81
  s_mov_b32 exec_hi, 0
  ds_write_b64 v28, v[80:81] offset:512
  s_mov_b64 exec, 1
  ds_add_u32 v1, v18 offset:20
  s_mov_b64 exec, -1
  v_and_b32 v22, 31, v0
  v_mul_u32_u24 v22, 640, v22
  v_lshl_add_u32 v22, v26, 2, v22
  s_mul_i32 s32, s28, 20480
  s_add_u32 s32, s32, 692224
  s_mul_i32 s33, s27, 640
  s_add_u32 s33, s33, s32
  s_lshl_b32 s35, s27, 5
  s_add_u32 s35, s35, s32
  s_lshl_b32 s34, s27, 3
  s_add_u32 s34, s34, s31
  v_mov_b32 v97, s60
  s_getreg_b32 s62, hwreg(HW_REG_XCC_ID, 0, 3)
  s_add_u32 s62, s62, s61
  v_mov_b32 v99, s62
  v_mov_b32 v101, s60
  v_mov_b32 v103, s61
  s_mov_b32 s71, 262144
  s_mov_b32 s72, 0
L_spin3:
  ds_read_b32 v8, v1 offset:8
  ds_read_b128 v[30:33], v1 offset:1280
  s_sub_u32 s71, s71, 1
  s_cbranch_scc1 L_spin3_x
  s_waitcnt lgkmcnt(1)
  v_readfirstlane_b32 s72, v8
  s_cmp_ge_u32 s72, 4
  s_cbranch_scc0 L_spin3
L_spin3_x:
  s_waitcnt lgkmcnt(0)
  v_max3_f32 v96, v30, v31, v32
  v_max_f32 v96, v96, v33
  v_sub_f32 v30, v30, v96
  v_sub_f32 v31, v31, v96
  v_sub_f32 v32, v32, v96
  v_sub_f32 v33, v33, v96
  v_mul_f32 v30, 0x3fb8aa3b, v30
  v_mul_f32 v31, 0x3fb8aa3b, v31
  v_mul_f32 v32, 0x3fb8aa3b, v32
  v_mul_f32 v33, 0x3fb8aa3b, v33
  v_exp_f32 v30, v30
  v_exp_f32 v31, v31
  v_exp_f32 v32, v32
  v_exp_f32 v33, v33
  s_mov_b32 s71, 262144
  s_mov_b32 s72, 0
L_spin4:
  ds_read_b32 v8, v1 offset:12
  ds_read_b64 v[34:35], v19 offset:1536
  ds_read_b64 v[36:37], v19 offset:2048
  ds_read_b64 v[38:39], v19 offset:2560
  ds_read_b64 v[40:41], v19 offset:3072
  ds_read_b128 v[44:47], v1 offset:1296
  s_sub_u32 s71, s71, 1
  s_cbranch_scc1 L_spin4_x
  s_waitcnt lgkmcnt(5)
  v_readfirstlane_b32 s72, v8
  s_cmp_ge_u32 s72, 4
  s_cbranch_scc0 L_spin4
L_spin4_x:
  s_waitcnt lgkmcnt(4)
  v_mul_f32 v100, v30, v34
  v_mul_f32 v102, v30, v35
  s_waitcnt lgkmcnt(3)
  v_fmac_f32 v100, v31, v36
  v_fmac_f32 v102, v31, v37
  s_waitcnt lgkmcnt(2)
  v_fmac_f32 v100, v32, v38
  v_fmac_f32 v102, v32, v39
  s_waitcnt lgkmcnt(1)
  v_fmac_f32 v100, v33, v40
  v_fmac_f32 v102, v33, v41
  buffer_store_dwordx4 v[100:103], v17, s[36:39], s75 offen
  s_waitcnt lgkmcnt(0)
  v_mul_f32 v98, v30, v44
  v_fmac_f32 v98, v31, v45
  v_fmac_f32 v98, v32, v46
  v_fmac_f32 v98, v33, v47
  s_mov_b64 exec, 0xff
  buffer_store_dwordx4 v[96:99], v17, s[36:39], s74 offen
  ds_add_u32 v1, v18 offset:24
  s_mov_b64 exec, -1
  s_cmp_lg_u32 s63, 0
  s_cbranch_scc1 L_x2l
  buffer_store_dwordx4 v[100:103], v17, s[36:39], s57 offen sc1
  s_mov_b64 exec, 0xff
  buffer_store_dwordx4 v[96:99], v17, s[36:39], s56 offen sc1
  s_mov_b64 exec, -1
L_x2l:
  s_movk_i32 s72, 3
  s_mov_b32 s71, 262144
  s_waitcnt vmcnt(0)
L_x2:
  buffer_load_dwordx4 v[80:83], v27, s[36:39], s73 offen sc1
  buffer_load_dwordx4 v[48:51], v17, s[36:39], s68 offen offset:0 sc1
  buffer_load_dwordx4 v[52:55], v17, s[36:39], s68 offen offset:1024 sc1
  buffer_load_dwordx4 v[56:59], v17, s[36:39], s68 offen offset:2048 sc1
  buffer_load_dwordx4 v[60:63], v17, s[36:39], s68 offen offset:3072 sc1
  buffer_load_dwordx4 v[64:67], v17, s[36:39], s69 offen offset:0 sc1
  buffer_load_dwordx4 v[68:71], v17, s[36:39], s69 offen offset:1024 sc1
  buffer_load_dwordx4 v[72:75], v17, s[36:39], s69 offen offset:2048 sc1
  buffer_load_dwordx4 v[76:79], v17, s[36:39], s69 offen offset:3072 sc1
  s_mov_b64 exec, 1
  ds_add_u32 v1, v18 offset:44
  s_mov_b64 exec, -1
  s_waitcnt vmcnt(8)
  v_max_f32_dpp v84, v80, v80 row_ror:4 row_mask:0xf bank_mask:0xf
  v_xor_b32 v4, s60, v81
  v_subrev_u32 v5, s61, v83
  v_max_f32_dpp v84, v84, v84 row_ror:2 row_mask:0xf bank_mask:0xf
  v_lshrrev_b32 v5, 3, v5
  v_or_b32 v4, v4, v5
  v_max_f32_dpp v84, v84, v84 row_ror:1 row_mask:0xf bank_mask:0xf
  v_sub_f32 v80, v80, v84
  v_mul_f32 v80, 0x3fb8aa3b, v80
  v_exp_f32 v80, v80
  s_waitcnt vmcnt(7)
  v_sad_u32 v4, v49, s60, v4 clamp
  v_sad_u32 v4, v51, s61, v4 clamp
  v_mul_f32 v82, v80, v82
  s_waitcnt vmcnt(6)
  v_sad_u32 v4, v53, s60, v4 clamp
  v_sad_u32 v4, v55, s61, v4 clamp
  v_add_f32_dpp v82, v82, v82 row_ror:4 row_mask:0xf bank_mask:0xf
  s_waitcnt vmcnt(5)
  v_sad_u32 v4, v57, s60, v4 clamp
  v_sad_u32 v4, v59, s61, v4 clamp
  v_add_f32_dpp v82, v82, v82 row_ror:2 row_mask:0xf bank_mask:0xf
  s_waitcnt vmcnt(4)
  v_sad_u32 v4, v61, s60, v4 clamp
  v_sad_u32 v4, v63, s61, v4 clamp
  v_add_f32_dpp v82, v82, v82 row_ror:1 row_mask:0xf bank_mask:0xf
  v_rcp_f32 v82, v82
  s_waitcnt vmcnt(3)
  v_sad_u32 v4, v65, s60, v4 clamp
  v_sad_u32 v4, v67, s61, v4 clamp
  v_mul_f32 v80, v80, v82
  s_waitcnt vmcnt(2)
  v_sad_u32 v4, v69, s60, v4 clamp
  v_sad_u32 v4, v71, s61, v4 clamp
  v_readlane_b32 s44, v80, 0
  v_readlane_b32 s45, v80, 1
  v_readlane_b32 s46, v80, 2
  v_readlane_b32 s47, v80, 3
  v_readlane_b32 s48, v80, 4
  v_readlane_b32 s49, v80, 5
  v_readlane_b32 s50, v80, 6
  v_readlane_b32 s51, v80, 7
  s_waitcnt vmcnt(1)
  v_sad_u32 v4, v73, s60, v4 clamp
  v_sad_u32 v4, v75, s61, v4 clamp
  s_waitcnt vmcnt(0)
  v_sad_u32 v4, v77, s60, v4 clamp
  v_sad_u32 v4, v79, s61, v4 clamp
  v_cmp_ne_u32 vcc, 0, v4
  v_mul_f32 v6, s44, v48
  v_mul_f32 v7, s44, v50
  v_fmac_f32 v6, s45, v52
  v_fmac_f32 v7, s45, v54
  v_fmac_f32 v6, s46, v56
  v_fmac_f32 v7, s46, v58
  v_fmac_f32 v6, s47, v60
  v_fmac_f32 v7, s47, v62
  v_fmac_f32 v6, s48, v64
  v_fmac_f32 v7, s48, v66
  v_fmac_f32 v6, s49, v68
  v_fmac_f32 v7, s49, v70
  v_fmac_f32 v6, s50, v72
  v_fmac_f32 v7, s50, v74
  v_fmac_f32 v6, s51, v76
  v_fmac_f32 v7, s51, v78
  v_cvt_pk_bf16_f32 v6, v6, v6
  v_cvt_pk_bf16_f32 v7, v7, v7
  s_cbranch_vccz L_x2ok
  s_sub_u32 s72, s72, 1
  s_cbranch_scc0 L_x2
  s_mov_b32 s72, 0
  buffer_store_dwordx4 v[100:103], v17, s[36:39], s57 offen sc1
  s_mov_b64 exec, 0xff
  buffer_store_dwordx4 v[96:99], v17, s[36:39], s56 offen sc1
  s_mov_b64 exec, -1
  buffer_store_dwordx4 v[104:107], v17, s[36:39], s58 offen sc1
  ds_read_b128 v[108:111], v17 offset:6400
  s_lshl_b32 s59, s66, 9
  s_add_u32 s59, s59, 266240
  s_mov_b32 exec_hi, 0
  s_waitcnt lgkmcnt(0)
  buffer_store_dwordx4 v[108:111], v17, s[36:39], s59 offen sc1
  s_mov_b64 exec, -1
  s_xor_b32 s68, s68, 1048576
  s_xor_b32 s69, s69, 1048576
  s_xor_b32 s73, s73, 1048576
  s_sub_u32 s71, s71, 1
  s_cbranch_scc0 L_x2
L_x2ok:
  ds_write_b64 v19, v[6:7] offset:768
  s_waitcnt lgkmcnt(0)
  s_barrier
  v_cmp_ne_u32 vcc, s62, v83
  s_cbranch_vccz L_same
  buffer_store_dwordx4 v[100:103], v17, s[36:39], s57 offen sc1
  s_mov_b64 exec, 0xff
  buffer_store_dwordx4 v[96:99], v17, s[36:39], s56 offen sc1
  s_mov_b64 exec, -1
  buffer_store_dwordx4 v[104:107], v17, s[36:39], s58 offen sc1
  ds_read_b128 v[108:111], v17 offset:6400
  s_lshl_b32 s59, s66, 9
  s_add_u32 s59, s59, 266240
  s_mov_b32 exec_hi, 0
  s_waitcnt lgkmcnt(0)
  buffer_store_dwordx4 v[108:111], v17, s[36:39], s59 offen sc1
  s_mov_b64 exec, -1
L_same:
  v_cmp_gt_u32 vcc, 40, v0
  v_lshlrev_b32 v4, 16, v25
  v_and_b32 v5, 0xffff0000, v25
  s_mov_b64 s[44:45], -1
  s_mov_b32 s71, 262144
  s_barrier
  ds_read_b64 v[32:33], v19 offset:3584
  ds_read_b64 v[34:35], v19 offset:4096
  ds_read_b64 v[36:37], v19 offset:4608
  ds_read_b64 v[38:39], v19 offset:5120
  s_waitcnt lgkmcnt(2)
  v_add_f32 v8, v32, v34
  v_add_f32 v10, v33, v35
  s_waitcnt lgkmcnt(0)
  v_add_f32 v36, v36, v38
  v_add_f32 v37, v37, v39
  s_mov_b64 exec, vcc
  v_add_f32 v8, v8, v36
  v_add_f32 v10, v10, v37
  buffer_store_dwordx4 v[8:11], v17, s[36:39], s33 offen sc1
  s_mov_b64 exec, -1
  s_cmp_ge_u32 s27, 20
  s_cbranch_scc1 L_Aend
  buffer_load_dwordx4 v[48:51], v22, s[36:39], s35 offen sc1
L_g3:
  s_mov_b64 exec, s[44:45]
  buffer_load_dwordx4 v[52:55], v22, s[36:39], s35 offen sc1
  s_mov_b64 exec, -1
  s_waitcnt vmcnt(1)
  v_xor_b32 v6, s60, v49
  v_xor_b32 v7, s61, v51
  v_or_b32 v6, v6, v7
  v_cmp_eq_u32 vcc, 0, v6
  s_nop 1
  v_cndmask_b32 v44, v44, v48, vcc
  v_cndmask_b32 v46, v46, v50, vcc
  s_andn2_b64 s[44:45], s[44:45], vcc
  s_cbranch_scc0 L_g3x
  s_mov_b64 exec, s[44:45]
  buffer_load_dwordx4 v[48:51], v22, s[36:39], s35 offen sc1
  s_mov_b64 exec, -1
  s_waitcnt vmcnt(1)
  v_xor_b32 v6, s60, v53
  v_xor_b32 v7, s61, v55
  v_or_b32 v6, v6, v7
  v_cmp_eq_u32 vcc, 0, v6
  s_nop 1
  v_cndmask_b32 v44, v44, v52, vcc
  v_cndmask_b32 v46, v46, v54, vcc
  s_andn2_b64 s[44:45], s[44:45], vcc
  s_cbranch_scc0 L_g3x
  s_sub_u32 s71, s71, 1
  s_cbranch_scc0 L_g3
L_g3x:
  v_add_f32_dpp v44, v44, v44 row_ror:1 row_mask:0xf bank_mask:0xf
  v_add_f32_dpp v46, v46, v46 row_ror:1 row_mask:0xf bank_mask:0xf
  s_nop 0
  v_add_f32_dpp v44, v44, v44 row_ror:2 row_mask:0xf bank_mask:0xf
  v_add_f32_dpp v46, v46, v46 row_ror:2 row_mask:0xf bank_mask:0xf
  s_nop 0
  v_add_f32_dpp v44, v44, v44 row_ror:4 row_mask:0xf bank_mask:0xf
  v_add_f32_dpp v46, v46, v46 row_ror:4 row_mask:0xf bank_mask:0xf
  s_nop 0
  v_add_f32_dpp v44, v44, v44 row_ror:8 row_mask:0xf bank_mask:0xf
  v_add_f32_dpp v46, v46, v46 row_ror:8 row_mask:0xf bank_mask:0xf
  s_nop 0
  v_add_f32_dpp v44, v44, v44 row_bcast:15 row_mask:0xa bank_mask:0xf
  v_add_f32_dpp v46, v46, v46 row_bcast:15 row_mask:0xa bank_mask:0xf
  s_mov_b32 exec_lo, 0x10000
  s_mov_b32 exec_hi, 0x10000
  v_add_f32 v44, v44, v4
  v_add_f32 v46, v46, v5
  v_cvt_pk_bf16_f32 v44, v44, v46
  buffer_store_dword v44, v26, s[52:55], s34 offen
  s_cmp_lg_u32 s29, 0
  s_cbranch_scc1 L_Aend
  s_add_u32 s30, s30, 1
  s_mov_b64 exec, 1
  v_mov_b32 v5, s30
  buffer_store_dword v5, v1, s[36:39], 0 offen offset:0 sc1
L_Aend:
  s_endpgm
L_KV:
  s_sub_u32 s51, s26, 2
  v_lshlrev_b32 v26, 4, v3
  v_lshl_add_u32 v24, v2, 8, v26
  v_lshl_add_u32 v25, v3, 10, v16
  s_lshl_b32 s48, s27, 20
  s_lshl_b32 s49, s28, 15
  s_add_u32 s48, s48, s49
  s_lshl_b32 s49, s51, 13
  s_add_u32 s48, s48, s49
  s_add_u32 s48, s48, 786432
  s_add_u32 s49, s48, 4096
  s_mov_b32 s40, s6
  s_mov_b32 s41, s7
  s_mov_b32 s42, 33554432
  s_mov_b32 s43, 0x20000
  buffer_load_dwordx4 v[64:67], v24, s[40:43], s48 offen offset:0
  buffer_load_dwordx4 v[68:71], v24, s[40:43], s48 offen offset:64
  buffer_load_dwordx4 v[72:75], v24, s[40:43], s48 offen offset:128
  buffer_load_dwordx4 v[76:79], v24, s[40:43], s48 offen offset:192
  s_mov_b32 s44, s8
  s_mov_b32 s45, s9
  s_mov_b32 s46, 33554432
  s_mov_b32 s47, 0x20000
  v_and_b32 v4, 1, v0
  v_lshlrev_b32 v4, 4, v4
  v_mov_b32 v5, 0xffff
  v_lshlrev_b32 v5, v4, v5
  v_bfe_u32 v4, v0, 1, 2
  v_cmp_eq_u32 vcc, 0, v4
  s_nop 1
  v_cndmask_b32 v12, 0, v5, vcc
  v_cmp_eq_u32 vcc, 1, v4
  s_nop 1
  v_cndmask_b32 v13, 0, v5, vcc
  v_cmp_eq_u32 vcc, 2, v4
  s_nop 1
  v_cndmask_b32 v14, 0, v5, vcc
  v_cmp_eq_u32 vcc, 3, v4
  s_nop 1
  v_cndmask_b32 v15, 0, v5, vcc
  s_lshl_b32 s32, s51, 9
  v_lshl_add_u32 v7, v2, 5, v26
  v_add_u32 v7, s32, v7
  s_mov_b32 s34, 0x3db504f3
  s_mov_b32 s35, 0x3db504f3
  s_mov_b32 s52, 0x3fb8aa3b
  s_mov_b32 s53, 0x3fb8aa3b
  s_lshl_b32 s32, s51, 2
  v_mov_b32 v6, s32
  s_mov_b32 s71, 262144
  s_mov_b32 s72, 0
L_spin5:
  ds_read_b32 v8, v1 offset:28
  s_sub_u32 s71, s71, 1
  s_cbranch_scc1 L_spin5_x
  s_waitcnt lgkmcnt(0)
  v_readfirstlane_b32 s72, v8
  s_cmp_ge_u32 s72, 1
  s_cbranch_scc0 L_spin5
L_spin5_x:
  buffer_load_dwordx4 v[80:83], v24, s[40:43], s49 offen offset:0
  buffer_load_dwordx4 v[84:87], v24, s[40:43], s49 offen offset:64
  buffer_load_dwordx4 v[88:91], v24, s[40:43], s49 offen offset:128
  s_waitcnt vmcnt(6)
  buffer_load_dwordx4 v[92:95], v24, s[40:43], s49 offen offset:192
  s_waitcnt vmcnt(6)
  buffer_load_dwordx4 v[96:99], v25, s[44:47], s48 offen offset:0 nt
  s_waitcnt vmcnt(6)
  buffer_load_dwordx4 v[100:103], v25, s[44:47], s48 offen offset:256 nt
  s_waitcnt vmcnt(6)
  buffer_load_dwordx4 v[104:107], v25, s[44:47], s48 offen offset:512 nt
  s_waitcnt vmcnt(6)
  buffer_load_dwordx4 v[108:111], v25, s[44:47], s48 offen offset:768 nt
  s_waitcnt vmcnt(6)
  buffer_load_dwordx4 v[112:115], v25, s[44:47], s49 offen offset:0 nt
  s_waitcnt vmcnt(6)
  buffer_load_dwordx4 v[116:119], v25, s[44:47], s49 offen offset:256 nt
  s_waitcnt vmcnt(6)
  buffer_load_dwordx4 v[120:123], v25, s[44:47], s49 offen offset:512 nt
  s_waitcnt vmcnt(6)
  buffer_load_dwordx4 v[124:127], v25, s[44:47], s49 offen offset:768 nt
  s_mov_b64 exec, 1
  ds_add_u32 v1, v18 offset:16
  s_mov_b64 exec, -1
  s_waitcnt vmcnt(8)
  s_mov_b32 s71, 262144
  s_mov_b32 s72, 0
L_spin6:
  ds_read_b32 v8, v1 offset:4
  ds_read_b128 v[48:51], v26 offset:256
  ds_read_b128 v[52:55], v26 offset:320
  ds_read_b128 v[56:59], v26 offset:384
  ds_read_b128 v[60:63], v26 offset:448
  s_sub_u32 s71, s71, 1
  s_cbranch_scc1 L_spin6_x
  s_waitcnt lgkmcnt(4)
  v_readfirstlane_b32 s72, v8
  s_cmp_ge_u32 s72, 1
  s_cbranch_scc0 L_spin6
L_spin6_x:
  s_waitcnt lgkmcnt(3)
  v_mfma_f32_16x16x32_bf16 v[36:39], v[64:67], v[48:51], 0
  v_mfma_f32_16x16x32_bf16 v[40:43], v[80:83], v[48:51], 0
  s_waitcnt lgkmcnt(2)
  v_mfma_f32_16x16x32_bf16 v[36:39], v[68:71], v[52:55], v[36:39]
  v_mfma_f32_16x16x32_bf16 v[40:43], v[84:87], v[52:55], v[40:43]
  s_waitcnt lgkmcnt(1)
  v_mfma_f32_16x16x32_bf16 v[36:39], v[72:75], v[56:59], v[36:39]
  v_mfma_f32_16x16x32_bf16 v[40:43], v[88:91], v[56:59], v[40:43]
  s_waitcnt lgkmcnt(0)
  v_mfma_f32_16x16x32_bf16 v[36:39], v[76:79], v[60:63], v[36:39]
  v_mfma_f32_16x16x32_bf16 v[40:43], v[92:95], v[60:63], v[40:43]
  s_nop 7
  v_cvt_pk_bf16_f32 v36, v36, v37
  v_cvt_pk_bf16_f32 v38, v38, v39
  v_cvt_pk_bf16_f32 v40, v40, v41
  v_cvt_pk_bf16_f32 v42, v42, v43
  v_and_b32 v37, 0xffff0000, v36
  v_lshlrev_b32 v36, 16, v36
  v_and_b32 v39, 0xffff0000, v38
  v_lshlrev_b32 v38, 16, v38
  v_and_b32 v41, 0xffff0000, v40
  v_lshlrev_b32 v40, 16, v40
  v_and_b32 v43, 0xffff0000, v42
  v_lshlrev_b32 v42, 16, v42
  v_pk_mul_f32 v[36:37], v[36:37], s[34:35]
  v_pk_mul_f32 v[38:39], v[38:39], s[34:35]
  v_pk_mul_f32 v[40:41], v[40:41], s[34:35]
  v_pk_mul_f32 v[42:43], v[42:43], s[34:35]
  v_cvt_pk_bf16_f32 v36, v36, v37
  v_cvt_pk_bf16_f32 v38, v38, v39
  v_cvt_pk_bf16_f32 v40, v40, v41
  v_cvt_pk_bf16_f32 v42, v42, v43
  v_and_b32 v37, 0xffff0000, v36
  v_lshlrev_b32 v36, 16, v36
  v_and_b32 v39, 0xffff0000, v38
  v_lshlrev_b32 v38, 16, v38
  v_and_b32 v41, 0xffff0000, v40
  v_lshlrev_b32 v40, 16, v40
  v_and_b32 v43, 0xffff0000, v42
  v_lshlrev_b32 v42, 16, v42
  v_max3_f32 v10, v36, v37, v38
  v_max3_f32 v11, v39, v40, v41
  v_max3_f32 v10, v10, v42, v43
  v_max_f32 v10, v10, v11
  v_mov_b32 v5, v10
  s_nop 1
  v_permlane16_swap_b32 v10, v5
  v_max_f32 v10, v10, v5
  v_mov_b32 v5, v10
  s_nop 1
  v_permlane32_swap_b32 v10, v5
  v_max_f32 v10, v10, v5
  v_pk_add_f32 v[36:37], v[36:37], v[10:11] op_sel_hi:[1,0] neg_lo:[0,1] neg_hi:[0,1]
  v_pk_add_f32 v[38:39], v[38:39], v[10:11] op_sel_hi:[1,0] neg_lo:[0,1] neg_hi:[0,1]
  v_pk_add_f32 v[40:41], v[40:41], v[10:11] op_sel_hi:[1,0] neg_lo:[0,1] neg_hi:[0,1]
  v_pk_add_f32 v[42:43], v[42:43], v[10:11] op_sel_hi:[1,0] neg_lo:[0,1] neg_hi:[0,1]
  v_pk_mul_f32 v[36:37], v[36:37], s[52:53]
  v_pk_mul_f32 v[38:39], v[38:39], s[52:53]
  v_pk_mul_f32 v[40:41], v[40:41], s[52:53]
  v_pk_mul_f32 v[42:43], v[42:43], s[52:53]
  v_exp_f32 v36, v36
  v_exp_f32 v37, v37
  v_exp_f32 v38, v38
  v_exp_f32 v39, v39
  v_exp_f32 v40, v40
  v_exp_f32 v41, v41
  v_exp_f32 v42, v42
  v_exp_f32 v43, v43
  s_mov_b64 exec, 1
  ds_write_b32 v6, v10 offset:1280
  ds_add_u32 v1, v18 offset:8
  s_mov_b64 exec, -1
  v_cvt_pk_bf16_f32 v28, v36, v36
  v_cvt_pk_bf16_f32 v29, v37, v37
  v_cvt_pk_bf16_f32 v30, v38, v38
  v_cvt_pk_bf16_f32 v31, v39, v39
  v_cvt_pk_bf16_f32 v32, v40, v40
  v_cvt_pk_bf16_f32 v33, v41, v41
  v_cvt_pk_bf16_f32 v34, v42, v42
  v_cvt_pk_bf16_f32 v35, v43, v43
  v_and_b32 v48, v28, v12
  v_and_b32 v49, v28, v13
  v_and_b32 v50, v28, v14
  v_and_b32 v51, v28, v15
  v_and_b32 v52, v29, v12
  v_and_b32 v53, v29, v13
  v_and_b32 v54, v29, v14
  v_and_b32 v55, v29, v15
  s_waitcnt vmcnt(7)
  v_mfma_f32_16x16x32_bf16 v[44:47], v[48:51], v[96:99], 0
  v_and_b32 v48, v30, v12
  v_and_b32 v49, v30, v13
  v_and_b32 v50, v30, v14
  v_and_b32 v51, v30, v15
  s_waitcnt vmcnt(6)
  v_mfma_f32_16x16x32_bf16 v[44:47], v[52:55], v[100:103], v[44:47]
  v_and_b32 v52, v31, v12
  v_and_b32 v53, v31, v13
  v_and_b32 v54, v31, v14
  v_and_b32 v55, v31, v15
  s_waitcnt vmcnt(5)
  v_mfma_f32_16x16x32_bf16 v[44:47], v[48:51], v[104:107], v[44:47]
  v_and_b32 v48, v32, v12
  v_and_b32 v49, v32, v13
  v_and_b32 v50, v32, v14
  v_and_b32 v51, v32, v15
  s_waitcnt vmcnt(4)
  v_mfma_f32_16x16x32_bf16 v[44:47], v[52:55], v[108:111], v[44:47]
  v_and_b32 v52, v33, v12
  v_and_b32 v53, v33, v13
  v_and_b32 v54, v33, v14
  v_and_b32 v55, v33, v15
  s_waitcnt vmcnt(3)
  v_mfma_f32_16x16x32_bf16 v[44:47], v[48:51], v[112:115], v[44:47]
  v_and_b32 v48, v34, v12
  v_and_b32 v49, v34, v13
  v_and_b32 v50, v34, v14
  v_and_b32 v51, v34, v15
  s_waitcnt vmcnt(2)
  v_mfma_f32_16x16x32_bf16 v[44:47], v[52:55], v[116:119], v[44:47]
  v_and_b32 v52, v35, v12
  v_and_b32 v53, v35, v13
  v_and_b32 v54, v35, v14
  v_and_b32 v55, v35, v15
  s_waitcnt vmcnt(1)
  v_mfma_f32_16x16x32_bf16 v[44:47], v[48:51], v[120:123], v[44:47]
  s_nop 0
  s_waitcnt vmcnt(0)
  v_mfma_f32_16x16x32_bf16 v[44:47], v[52:55], v[124:127], v[44:47]
  v_add_f32 v11, v36, v37
  v_add_f32 v10, v38, v39
  v_add_f32 v11, v11, v40
  v_add_f32 v10, v10, v41
  v_add_f32 v11, v11, v42
  v_add_f32 v10, v10, v43
  v_add_f32 v11, v11, v10
  s_mov_b32 exec_hi, 0
  s_nop 0
  ds_write_b128 v7, v[44:47] offset:1536
  s_mov_b64 exec, -1
  v_mov_b32 v5, v11
  s_nop 1
  v_permlane16_swap_b32 v11, v5
  v_add_f32 v11, v11, v5
  v_mov_b32 v5, v11
  s_nop 1
  v_permlane32_swap_b32 v11, v5
  v_add_f32 v11, v11, v5
  s_mov_b64 exec, 1
  ds_write_b32 v6, v11 offset:1296
  ds_add_u32 v1, v18 offset:12
  s_endpgm
L_B:
  s_load_dword s30, s[24:25], 0
  s_mov_b32 s36, s24
  s_mov_b32 s37, s25
  s_mov_b32 s38, 268435456
  s_mov_b32 s39, 0x20000
  v_mul_u32_u24 v28, 40, v6
  v_lshlrev_b32 v29, 4, v7
  v_lshl_add_u32 v29, v3, 7, v29
  v_and_b32 v4, 1, v0
  v_lshlrev_b32 v4, 4, v4
  v_mov_b32 v5, 0xffff
  v_lshlrev_b32 v5, v4, v5
  v_bfe_u32 v4, v0, 1, 2
  v_cmp_eq_u32 vcc, 0, v4
  s_nop 1
  v_cndmask_b32 v12, 0, v5, vcc
  v_cmp_eq_u32 vcc, 1, v4
  s_nop 1
  v_cndmask_b32 v13, 0, v5, vcc
  v_cmp_eq_u32 vcc, 2, v4
  s_nop 1
  v_cndmask_b32 v14, 0, v5, vcc
  v_cmp_eq_u32 vcc, 3, v4
  s_nop 1
  v_cndmask_b32 v15, 0, v5, vcc
  s_mov_b32 s64, 0
  s_mov_b32 s65, -1
  s_mov_b32 s71, 262144
  s_mov_b32 s72, 0
L_spin7:
  ds_read_b32 v8, v1 offset:0
  s_sub_u32 s71, s71, 1
  s_cbranch_scc1 L_spin7_x
  s_waitcnt lgkmcnt(0)
  v_readfirstlane_b32 s72, v8
  s_cmp_ge_u32 s72, 1
  s_cbranch_scc0 L_spin7
L_spin7_x:
  ds_read_b64 v[30:31], v28 offset:5632
  ds_read_b64 v[32:33], v28 offset:5640
  ds_read_b64 v[34:35], v28 offset:5648
  ds_read_b64 v[36:37], v28 offset:5656
  ds_read_b64 v[38:39], v28 offset:5664
  s_waitcnt lgkmcnt(0)
  s_mul_i32 s60, s30, 0x9E3779B1
  s_add_u32 s60, s60, 0x7F4A7C15
  s_xor_b32 s61, s30, 0x5bd1e995
  s_mul_i32 s61, s61, 0x85EBCA6B
  s_add_u32 s61, s61, 0x1B873593
  v_and_b32 v40, v30, v12
  v_and_b32 v41, v30, v13
  v_and_b32 v42, v30, v14
  v_and_b32 v43, v30, v15
  v_and_b32 v44, v31, v12
  v_and_b32 v45, v31, v13
  v_and_b32 v46, v31, v14
  v_and_b32 v47, v31, v15
  s_waitcnt vmcnt(9)
  v_mfma_f32_16x16x32_bf16 v[4:7], v[40:43], v[48:51], 0
  v_and_b32 v40, v32, v12
  v_and_b32 v41, v32, v13
  v_and_b32 v42, v32, v14
  v_and_b32 v43, v32, v15
  s_waitcnt vmcnt(8)
  v_mfma_f32_16x16x32_bf16 v[4:7], v[44:47], v[52:55], v[4:7]
  v_and_b32 v44, v33, v12
  v_and_b32 v45, v33, v13
  v_and_b32 v46, v33, v14
  v_and_b32 v47, v33, v15
  s_waitcnt vmcnt(7)
  v_mfma_f32_16x16x32_bf16 v[4:7], v[40:43], v[56:59], v[4:7]
  v_and_b32 v40, v34, v12
  v_and_b32 v41, v34, v13
  v_and_b32 v42, v34, v14
  v_and_b32 v43, v34, v15
  s_waitcnt vmcnt(6)
  v_mfma_f32_16x16x32_bf16 v[4:7], v[44:47], v[60:63], v[4:7]
  v_and_b32 v44, v35, v12
  v_and_b32 v45, v35, v13
  v_and_b32 v46, v35, v14
  v_and_b32 v47, v35, v15
  s_waitcnt vmcnt(5)
  v_mfma_f32_16x16x32_bf16 v[4:7], v[40:43], v[64:67], v[4:7]
  v_and_b32 v40, v36, v12
  v_and_b32 v41, v36, v13
  v_and_b32 v42, v36, v14
  v_and_b32 v43, v36, v15
  s_waitcnt vmcnt(4)
  v_mfma_f32_16x16x32_bf16 v[4:7], v[44:47], v[68:71], v[4:7]
  v_and_b32 v44, v37, v12
  v_and_b32 v45, v37, v13
  v_and_b32 v46, v37, v14
  v_and_b32 v47, v37, v15
  s_waitcnt vmcnt(3)
  v_mfma_f32_16x16x32_bf16 v[4:7], v[40:43], v[72:75], v[4:7]
  v_and_b32 v40, v38, v12
  v_and_b32 v41, v38, v13
  v_and_b32 v42, v38, v14
  v_and_b32 v43, v38, v15
  s_waitcnt vmcnt(2)
  v_mfma_f32_16x16x32_bf16 v[4:7], v[44:47], v[76:79], v[4:7]
  v_and_b32 v44, v39, v12
  v_and_b32 v45, v39, v13
  v_and_b32 v46, v39, v14
  v_and_b32 v47, v39, v15
  s_waitcnt vmcnt(1)
  v_mfma_f32_16x16x32_bf16 v[4:7], v[40:43], v[80:83], v[4:7]
  s_nop 0
  s_waitcnt vmcnt(0)
  v_mfma_f32_16x16x32_bf16 v[4:7], v[44:47], v[84:87], v[4:7]
  v_mov_b32 v9, s60
  v_mov_b32 v11, s61
  s_lshl_b32 s32, s66, 9
  s_add_u32 s32, s32, 266240
  s_nop 4
  v_mov_b32_dpp v20, v4 row_ror:8 row_mask:0xf bank_mask:0xf
  v_mov_b32_dpp v21, v5 row_ror:8 row_mask:0xf bank_mask:0xf
  v_mov_b32_dpp v22, v6 row_ror:8 row_mask:0xf bank_mask:0xf
  v_mov_b32_dpp v23, v7 row_ror:8 row_mask:0xf bank_mask:0xf
  v_mov_b32 v30, v20
  v_mov_b32 v31, v21
  v_mov_b32 v32, v22
  v_mov_b32 v33, v23
  s_nop 1
  v_permlane32_swap_b32 v20, v30
  v_permlane32_swap_b32 v21, v31
  v_permlane32_swap_b32 v22, v32
  v_permlane32_swap_b32 v23, v33
  v_cndmask_b32 v20, v30, v20, s[64:65]
  v_cndmask_b32 v21, v31, v21, s[64:65]
  v_cndmask_b32 v22, v32, v22, s[64:65]
  v_cndmask_b32 v23, v33, v23, s[64:65]
  v_add_f32 v4, v4, v20
  v_add_f32 v5, v5, v21
  v_add_f32 v6, v6, v22
  v_add_f32 v7, v7, v23
  v_cndmask_b32 v8, v4, v6, s[64:65]
  v_cndmask_b32 v10, v5, v7, s[64:65]
  s_mov_b32 exec_lo, 0x00ff00ff
  s_mov_b32 exec_hi, 0xff00ff00
  ds_write_b128 v29, v[8:11] offset:6400
  s_waitcnt lgkmcnt(0)
  s_add_u32 s33, s32, 1048576
  buffer_store_dwordx4 v[8:11], v29, s[36:39], s33 offen
  s_mov_b64 exec, 1
  ds_add_u32 v1, v18 offset:32
  s_mov_b64 exec, -1
  s_endpgm
L_W:
  s_sub_u32 s51, s26, 6
  v_and_b32 v4, 1, v0
  v_lshlrev_b32 v4, 4, v4
  v_mov_b32 v5, 0xffff
  v_lshlrev_b32 v5, v4, v5
  v_bfe_u32 v4, v0, 1, 2
  v_cmp_eq_u32 vcc, 0, v4
  s_nop 1
  v_cndmask_b32 v12, 0, v5, vcc
  v_cmp_eq_u32 vcc, 1, v4
  s_nop 1
  v_cndmask_b32 v13, 0, v5, vcc
  v_cmp_eq_u32 vcc, 2, v4
  s_nop 1
  v_cndmask_b32 v14, 0, v5, vcc
  v_cmp_eq_u32 vcc, 3, v4
  s_nop 1
  v_cndmask_b32 v15, 0, v5, vcc
  v_cmp_gt_u32 vcc, 10, v2
  v_mov_b32 v4, 0x7f000000
  s_nop 0
  v_cndmask_b32 v4, v4, v16, vcc
  v_mul_u32_u24 v5, 5120, v3
  v_add_u32 v5, v5, v4
  v_mul_u32_u24 v6, 10240, v3
  v_add_u32 v6, v6, v4
  s_lshl_b32 s32, s27, 2
  s_add_u32 s32, s32, s51
  s_mul_i32 s33, s32, 40960
  s_mul_i32 s32, s32, 20480
  s_add_u32 s32, s32, s31
  s_add_u32 s33, s33, s31
  s_add_u32 s35, s33, 5120
  s_cmp_ge_u32 s27, 27
  s_cselect_b32 s32, 0x7f000000, s32
  s_lshl_b32 s34, s51, 6
  v_lshl_add_u32 v11, v3, 4, s34
  s_lshl_b32 s34, s51, 7
  v_lshl_add_u32 v7, v3, 5, s34
  s_lshl_b32 s34, s51, 9
  v_lshlrev_b32 v10, 4, v3
  v_lshl_add_u32 v10, v2, 5, v10
  v_add_u32 v10, s34, v10
  s_mov_b32 s40, s18
  s_mov_b32 s41, s19
  s_mov_b32 s42, 2211840
  s_mov_b32 s43, 0x20000
  s_mov_b32 s44, s12
  s_mov_b32 s45, s13
  s_mov_b32 s46, 5242880
  s_mov_b32 s47, 0x20000
  s_waitcnt vmcnt(0)
  s_mov_b32 s71, 262144
  s_mov_b32 s72, 0
L_spin8:
  ds_read_b32 v8, v1 offset:16
  s_sub_u32 s71, s71, 1
  s_cbranch_scc1 L_spin8_x
  s_waitcnt lgkmcnt(0)
  v_readfirstlane_b32 s72, v8
  s_cmp_ge_u32 s72, 4
  s_cbranch_scc0 L_spin8
L_spin8_x:
  buffer_load_dwordx4 v[48:51], v5, s[40:43], s32 offen offset:0 nt
  buffer_load_dwordx4 v[52:55], v5, s[40:43], s32 offen offset:1280 nt
  buffer_load_dwordx4 v[56:59], v5, s[40:43], s32 offen offset:2560 nt
  buffer_load_dwordx4 v[60:63], v5, s[40:43], s32 offen offset:3840 nt
  buffer_load_dwordx4 v[64:67], v6, s[44:47], s33 offen offset:0 nt
  buffer_load_dwordx4 v[68:71], v6, s[44:47], s33 offen offset:1280 nt
  s_mov_b32 s71, 262144
  s_mov_b32 s72, 0
L_spin9:
  ds_read_b32 v8, v1 offset:24
  s_sub_u32 s71, s71, 1
  s_cbranch_scc1 L_spin9_x
  s_waitcnt lgkmcnt(0)
  v_readfirstlane_b32 s72, v8
  s_cmp_ge_u32 s72, 1
  s_cbranch_scc0 L_spin9
L_spin9_x:
  buffer_load_dwordx4 v[72:75], v6, s[44:47], s33 offen offset:2560 nt
  buffer_load_dwordx4 v[76:79], v6, s[44:47], s33 offen offset:3840 nt
  s_mov_b32 s71, 262144
  s_mov_b32 s72, 0
L_spin10:
  ds_read_b32 v8, v1 offset:44
  s_sub_u32 s71, s71, 1
  s_cbranch_scc1 L_spin10_x
  s_waitcnt lgkmcnt(0)
  v_readfirstlane_b32 s72, v8
  s_cmp_ge_u32 s72, 1
  s_cbranch_scc0 L_spin10
L_spin10_x:
  buffer_load_dwordx4 v[80:83], v6, s[44:47], s35 offen offset:0 nt
  buffer_load_dwordx4 v[84:87], v6, s[44:47], s35 offen offset:1280 nt
  buffer_load_dwordx4 v[88:91], v6, s[44:47], s35 offen offset:2560 nt
  buffer_load_dwordx4 v[92:95], v6, s[44:47], s35 offen offset:3840 nt
  s_mov_b32 s71, 262144
  s_mov_b32 s72, 0
L_spin11:
  ds_read_b32 v8, v1 offset:20
  ds_read_b128 v[20:23], v11 offset:512
  s_sub_u32 s71, s71, 1
  s_cbranch_scc1 L_spin11_x
  s_waitcnt lgkmcnt(1)
  v_readfirstlane_b32 s72, v8
  s_cmp_ge_u32 s72, 1
  s_cbranch_scc0 L_spin11
L_spin11_x:
  s_waitcnt lgkmcnt(0)
  v_and_b32 v40, v20, v12
  v_and_b32 v41, v20, v13
  v_and_b32 v42, v20, v14
  v_and_b32 v43, v20, v15
  v_and_b32 v44, v21, v12
  v_and_b32 v45, v21, v13
  v_and_b32 v46, v21, v14
  v_and_b32 v47, v21, v15
  s_waitcnt vmcnt(11)
  v_mfma_f32_16x16x32_bf16 v[36:39], v[40:43], v[48:51], 0
  v_and_b32 v40, v22, v12
  v_and_b32 v41, v22, v13
  v_and_b32 v42, v22, v14
  v_and_b32 v43, v22, v15
  s_waitcnt vmcnt(10)
  v_mfma_f32_16x16x32_bf16 v[36:39], v[44:47], v[52:55], v[36:39]
  v_and_b32 v44, v23, v12
  v_and_b32 v45, v23, v13
  v_and_b32 v46, v23, v14
  v_and_b32 v47, v23, v15
  s_waitcnt vmcnt(9)
  v_mfma_f32_16x16x32_bf16 v[36:39], v[40:43], v[56:59], v[36:39]
  s_nop 0
  s_waitcnt vmcnt(8)
  v_mfma_f32_16x16x32_bf16 v[36:39], v[44:47], v[60:63], v[36:39]
  s_barrier
  ds_read_b128 v[20:23], v7 offset:768
  ds_read_b128 v[24:27], v7 offset:784
  s_waitcnt lgkmcnt(1)
  v_and_b32 v40, v20, v12
  v_and_b32 v41, v20, v13
  v_and_b32 v42, v20, v14
  v_and_b32 v43, v20, v15
  v_and_b32 v44, v21, v12
  v_and_b32 v45, v21, v13
  v_and_b32 v46, v21, v14
  v_and_b32 v47, v21, v15
  s_waitcnt vmcnt(7)
  v_mfma_f32_16x16x32_bf16 v[36:39], v[40:43], v[64:67], v[36:39]
  v_and_b32 v40, v22, v12
  v_and_b32 v41, v22, v13
  v_and_b32 v42, v22, v14
  v_and_b32 v43, v22, v15
  s_waitcnt vmcnt(6)
  v_mfma_f32_16x16x32_bf16 v[36:39], v[44:47], v[68:71], v[36:39]
  v_and_b32 v44, v23, v12
  v_and_b32 v45, v23, v13
  v_and_b32 v46, v23, v14
  v_and_b32 v47, v23, v15
  s_waitcnt vmcnt(5)
  v_mfma_f32_16x16x32_bf16 v[36:39], v[40:43], v[72:75], v[36:39]
  s_waitcnt lgkmcnt(0)
  v_and_b32 v40, v24, v12
  v_and_b32 v41, v24, v13
  v_and_b32 v42, v24, v14
  v_and_b32 v43, v24, v15
  s_waitcnt vmcnt(4)
  v_mfma_f32_16x16x32_bf16 v[36:39], v[44:47], v[76:79], v[36:39]
  v_and_b32 v44, v25, v12
  v_and_b32 v45, v25, v13
  v_and_b32 v46, v25, v14
  v_and_b32 v47, v25, v15
  s_waitcnt vmcnt(3)
  v_mfma_f32_16x16x32_bf16 v[36:39], v[40:43], v[80:83], v[36:39]
  v_and_b32 v40, v26, v12
  v_and_b32 v41, v26, v13
  v_and_b32 v42, v26, v14
  v_and_b32 v43, v26, v15
  s_waitcnt vmcnt(2)
  v_mfma_f32_16x16x32_bf16 v[36:39], v[44:47], v[84:87], v[36:39]
  v_and_b32 v44, v27, v12
  v_and_b32 v45, v27, v13
  v_and_b32 v46, v27, v14
  v_and_b32 v47, v27, v15
  s_waitcnt vmcnt(1)
  v_mfma_f32_16x16x32_bf16 v[36:39], v[40:43], v[88:91], v[36:39]
  s_nop 0
  s_waitcnt vmcnt(0)
  v_mfma_f32_16x16x32_bf16 v[36:39], v[44:47], v[92:95], v[36:39]
  s_mov_b32 exec_hi, 0
  s_nop 7
  ds_write_b128 v10, v[36:39] offset:3584
  s_waitcnt lgkmcnt(0)
  s_barrier
L_end:
s_endpgm
.fill 512, 4, 0xBF800000
.section .rodata,"a"
.p2align 6
.amdhsa_kernel parallel_sum__sliding_block_cached__dense_activation_silu__decode_kernel
  .amdhsa_next_free_vgpr 128
  .amdhsa_next_free_sgpr 102
  .amdhsa_accum_offset 128
  .amdhsa_group_segment_fixed_size 0
  .amdhsa_kernarg_size 88
  .amdhsa_user_sgpr_count 2
  .amdhsa_user_sgpr_kernarg_segment_ptr 1
  .amdhsa_system_sgpr_workgroup_id_x 1
.end_amdhsa_kernel
```
